```python
import torch

def _softmax(x, axis=-1):
    return torch.softmax(x, dim=axis)
def _gelu(x):
    return torch.nn.functional.gelu(x, approximate="tanh")
def _silu(x):
    return torch.nn.functional.silu(x)
def _sigmoid(x):
    return torch.sigmoid(x)
def _layernorm(x, axis=-1, eps=1e-5):
    m = x.mean(dim=axis, keepdim=True)
    v = x.var(dim=axis, keepdim=True, unbiased=False)
    return (x - m) / torch.sqrt(v + eps)
def _scatter_add(tgt, idx, src, axis=0):
    return tgt.clone().index_add_(axis, idx, src)
def _segment_sum(src, seg, n):
    out = torch.zeros((n,) + src.shape[1:], dtype=src.dtype)
    return out.index_add_(0, seg, src)
def _pad(x, pw):
    flat = tuple(v for pair in reversed(pw) for v in pair)
    return torch.nn.functional.pad(x, flat)

kernel_name = 'recurrent_scan__sliding_block_cached__glu_gated_glu__decode'

def setup_inputs():

    _w = (lambda a: (lambda t: t.to(torch.bfloat16) if t.is_floating_point() else t)(torch.as_tensor(a)))
    def _A_setup():
        B, Sq, D = 2, 1, 512
        Hq, Hkv, Sk, Dh = 32, 8, 32768, 128
        assert Hq % Hkv == 0, (Hq, Hkv)
        return {
            "x": _w((lambda *s: torch.randn(*s, dtype=torch.bfloat16) * 0.05)(B, Sq, D)),
            "k_cache": _w((lambda *s: torch.randn(*s, dtype=torch.bfloat16) * 1.6)(B, Hkv, Sk, Dh)),
            "v_cache": _w((lambda *s: torch.randn(*s, dtype=torch.bfloat16) * 0.2)(B, Hkv, Sk, Dh)),
            "wq": _w((lambda *s: torch.randn(*s, dtype=torch.bfloat16) * 1.6)(D, Hq * Dh) * (D ** -0.5)),
            "wo": _w((lambda *s: torch.randn(*s, dtype=torch.bfloat16) * 0.2)(Hq * Dh, D) * ((Hq * Dh) ** -0.5)),
        }
    _A_in = _A_setup()

    def _B_setup():
        B, S, D, F = 2, 1, 512, 1792
        return {
            "x": _w((lambda *s: torch.randn(*s, dtype=torch.bfloat16) * 0.05)(B, S, D)),
            "w_gate": _w((lambda *s: torch.randn(*s, dtype=torch.bfloat16) * 1.6)(D, F)),
            "w_up": _w((lambda *s: torch.randn(*s, dtype=torch.bfloat16) * 0.1)(D, F)),
            "w_down": _w((lambda *s: torch.randn(*s, dtype=torch.bfloat16) * 0.1)(F, D)),
        }
    _B_in = _B_setup()

    return {
        "A_x": _A_in["x"],
        "A_k_cache": _A_in["k_cache"],
        "A_v_cache": _A_in["v_cache"],
        "A_wq": _A_in["wq"],
        "A_wo": _A_in["wo"],
        "B_x": _B_in["x"],
        "B_w_gate": _B_in["w_gate"],
        "B_w_up": _B_in["w_up"],
        "B_w_down": _B_in["w_down"],
    }

def reference(A_x, A_k_cache, A_v_cache, A_wq, A_wo, B_x, B_w_gate, B_w_up, B_w_down):
    def _A_ref(x, k_cache, v_cache, wq, wo):
        B, Sq, D = x.shape
        Hq, Dh = 32, 128
        Hkv, Sk = k_cache.shape[1], k_cache.shape[2]
        W = min(4096, max(256, Sk // 4))
        rep = Hq // Hkv
        q = (lambda x, *d: x.permute(*d))((x @ wq).reshape(B, Sq, Hq, Dh), 0, 2, 1, 3)
        k = (lambda x, n, axis: torch.repeat_interleave(x, n, dim=axis))(k_cache[:, :, Sk - W:, :], rep, axis=1)
        v = (lambda x, n, axis: torch.repeat_interleave(x, n, dim=axis))(v_cache[:, :, Sk - W:, :], rep, axis=1)
        scores = torch.einsum("bhqd,bhkd->bhqk", q, k) * (Dh ** -0.5)
        p = _softmax(scores, axis=-1)
        o = torch.einsum("bhqk,bhkd->bhqd", p, v)
        return (lambda x, *d: x.permute(*d))(o, 0, 2, 1, 3).reshape(B, Sq, Hq * Dh) @ wo

    def _B_ref(x, w_gate, w_up, w_down):
        g = torch.einsum("bsd,df->bsf", x, w_gate)
        u = torch.einsum("bsd,df->bsf", x, w_up)
        h = _sigmoid(g) * u
        return torch.einsum("bsf,fd->bsd", h, w_down)

    x = A_x
    xn = _layernorm(x, axis=-1)
    s = _A_ref(xn, A_k_cache, A_v_cache, A_wq, A_wo)
    g = _silu(_B_ref(xn, B_w_gate, B_w_up, B_w_down))
    return x + s * g
```

```asm
; @launch grid=(256,1,1) block=(768,1,1) lds=163840
.amdgcn_target "amdgcn-amd-amdhsa--gfx950"
.text
.globl recurrent_scan__sliding_block_cached__glu_gated_glu__decode_kernel
.p2align 8
.type recurrent_scan__sliding_block_cached__glu_gated_glu__decode_kernel,@function
recurrent_scan__sliding_block_cached__glu_gated_glu__decode_kernel:
    s_load_dwordx2 s[36:37], s[0:1], 0
    s_load_dwordx2 s[12:13], s[0:1], 24
    s_cmpk_ge_u32 s2, 256
    s_cbranch_scc1 L_exit
    v_lshrrev_b32 v1, 6, v0
    v_and_b32 v0, 63, v0
    s_lshr_b32 s50, s2, 3
    v_readfirstlane_b32 s3, v1
    s_and_b32 s49, s2, 7
    s_and_b32 s51, s50, 7
    s_lshr_b32 s52, s50, 3
    s_cmp_ge_u32 s3, 4
    s_cbranch_scc1 L_compute
    s_movk_i32 s38, 2048
    s_setprio 3
    s_lshl_b32 s39, 1, 17
    v_lshlrev_b32 v9, 4, v0
    s_and_b32 s56, s3, 1
    s_lshl_b32 s57, s56, 10
    s_mulk_i32 s56, 1088
    s_add_u32 m0, s56, 158208
    s_lshl_b32 s14, 1, 22
    s_mov_b32 s15, s39
    v_and_b32 v2, 7, v0
    v_lshlrev_b32 v2, 4, v2
    s_waitcnt lgkmcnt(0)
    buffer_load_dwordx4 v9, s[36:39], s57 offen lds
    v_lshrrev_b32 v3, 4, v0
    v_lshlrev_b32 v3, 5, v3
    v_xor_b32 v2, v2, v3
    v_lshrrev_b32 v1, 3, v0
    v_lshl_add_u32 v10, v1, 13, v2
    s_lshl4_add_u32 s55, s52, s3
    s_lshl_b32 s55, s55, 6
    s_add_u32 s55, s55, s49
    s_lshl3_add_u32 s55, s55, s51
    s_lshl_b32 s55, s55, 7
    s_lshl_b32 s61, s3, 10
    s_add_u32 m0, s61, 98304
    s_lshl_b32 s47, 1, 18
    buffer_load_dwordx4 v10, s[12:15], s55 offen nt lds
    s_addk_i32 m0, 4096
    s_add_u32 s55, s55, s47
    buffer_load_dwordx4 v10, s[12:15], s55 offen nt lds
    s_addk_i32 m0, 4096
    s_add_u32 s55, s55, s47
    buffer_load_dwordx4 v10, s[12:15], s55 offen nt lds
    s_addk_i32 m0, 4096
    s_add_u32 s55, s55, s47
    buffer_load_dwordx4 v10, s[12:15], s55 offen nt lds
    s_load_dwordx2 s[20:21], s[0:1], 48
    s_load_dwordx2 s[24:25], s[0:1], 56
    s_load_dwordx2 s[4:5], s[0:1], 8
    s_load_dwordx2 s[8:9], s[0:1], 16
    s_load_dwordx2 s[28:29], s[0:1], 64
    s_load_dwordx2 s[16:17], s[0:1], 32
    s_cmp_lg_u32 s3, 0
    s_cbranch_scc1 L_noinit
    v_lshlrev_b32 v4, 2, v0
    v_add_u32 v4, 155648, v4
    v_mov_b32 v5, 0
    s_mov_b64 exec, 0xffff
    ds_write_b32 v4, v5
    s_mov_b64 exec, -1
L_noinit:
    v_mul_u32_u24 v5, 3584, v1
    v_add_u32 v11, v5, v2
    v_lshl_add_u32 v12, v1, 10, v2
    s_mov_b32 s22, 1835008
    s_mov_b32 s23, s39
    s_mov_b32 s26, s22
    s_mov_b32 s27, s39
    s_mov_b32 s30, s22
    s_mov_b32 s31, s39
    s_lshl_b32 s6, 1, 27
    s_mov_b32 s7, s39
    s_mov_b32 s10, s6
    s_mov_b32 s11, s39
    s_mov_b32 s18, s14
    s_mov_b32 s19, s39
    s_lshr_b32 s53, s50, 4
    s_and_b32 s54, s50, 15
    s_add_u32 s57, s51, 0
    s_and_b32 s57, s57, 7
    s_lshl_b32 s57, s57, 7
    s_lshl3_add_u32 s58, s52, s49
    s_cmp_ge_u32 s58, 28
    s_cselect_b32 s59, 1073741824, 0
    s_lshl3_add_u32 s56, s51, s3
    s_mulk_i32 s56, 28672
    s_lshl_b32 s60, s58, 7
    s_add_u32 s56, s56, s60
    s_add_u32 s56, s56, s59
    v_lshrrev_b32 v1, 4, v0
    v_and_b32 v2, 15, v0
    v_xor_b32 v3, v2, v1
    v_lshlrev_b32 v3, 4, v3
    v_lshl_add_u32 v13, v1, 8, v3
    v_xor_b32 v14, 64, v13
    v_xor_b32 v15, 128, v13
    v_xor_b32 v16, 192, v13
    v_lshrrev_b32 v3, 1, v2
    v_xor_b32 v3, v3, v1
    v_lshlrev_b32 v3, 5, v3
    v_and_b32 v4, 1, v0
    v_lshl_add_u32 v3, v4, 4, v3
    v_lshl_add_u32 v17, v1, 8, v3
    v_xor_b32 v18, 128, v17
    s_lshl_b32 s62, s53, 3
    s_add_u32 s62, s62, s49
    s_lshl_b32 s62, s62, 23
    s_add_u32 s62, s62, 7340032
    s_mov_b32 s63, 0
    s_bitcmp1_b32 s3, 0
    s_cselect_b32 s93, 4096, 0
    s_xor_b32 s63, s63, s93
    s_bitcmp1_b32 s3, 1
    s_cselect_b32 s93, 2048, 0
    s_xor_b32 s63, s63, s93
    s_bitcmp1_b32 s54, 0
    s_cselect_b32 s93, 65536, 0
    s_xor_b32 s63, s63, s93
    s_bitcmp1_b32 s54, 1
    s_cselect_b32 s93, 32768, 0
    s_xor_b32 s63, s63, s93
    s_bitcmp1_b32 s54, 2
    s_cselect_b32 s93, 131072, 0
    s_xor_b32 s63, s63, s93
    s_bitcmp1_b32 s54, 3
    s_cselect_b32 s93, 264192, 0
    s_xor_b32 s63, s63, s93
    s_bitcmp1_b32 s49, 1
    s_cselect_b32 s93, 524288, 0
    s_xor_b32 s63, s63, s93
    s_bitcmp1_b32 s49, 2
    s_cselect_b32 s93, 16384, 0
    s_xor_b32 s63, s63, s93
    s_add_u32 s62, s62, s63
    s_mov_b32 s63, 0
    s_lshl_b32 s63, s63, 12
    s_add_u32 s62, s62, s63
    s_lshl_b32 s63, s49, 2
    s_add_u32 s63, s63, s52
    s_lshl_b32 s63, s63, 4
    s_add_u32 s63, s63, s3
    s_lshl_b32 s63, s63, 13
    s_add_u32 s63, s63, s57
    s_lshl_b32 s60, s58, 3
    s_add_u32 s60, s60, s3
    s_lshl_b32 s60, s60, 13
    s_add_u32 s60, s60, s57
    s_add_u32 s60, s60, s59
    s_lshl_b32 s58, s3, 2
    s_add_u32 s58, s58, 155648
    v_mov_b32 v20, s58
    v_lshlrev_b32 v22, 2, v2
    v_add_u32 v22, 155648, v22
    s_lshl_b32 s58, s3, 12
    s_waitcnt lgkmcnt(0)
    s_add_u32 m0, s61, 114688
    s_nop 0
    buffer_load_dwordx4 v11, s[20:23], s56 offen nt lds
    s_barrier
    s_add_u32 m0, s61, 118784
    s_add_u32 s46, s56, 114688
    s_waitcnt vmcnt(5)
    buffer_load_dwordx4 v11, s[20:23], s46 offen nt lds
    v_mov_b32 v21, 1
    s_mov_b64 exec, 1
    ds_write_b32 v20, v21
    s_mov_b64 exec, -1
    s_add_u32 m0, s61, 122880
    s_waitcnt vmcnt(5)
    buffer_load_dwordx4 v11, s[24:27], s56 offen nt lds
    s_add_u32 m0, s61, 126976
    s_add_u32 s46, s56, 114688
    s_waitcnt vmcnt(5)
    buffer_load_dwordx4 v11, s[24:27], s46 offen nt lds
    s_add_u32 m0, s58, 0
    s_xor_b32 s96, s62, 0
    s_waitcnt vmcnt(4)
    buffer_load_dwordx4 v13, s[4:7], s96 offen nt lds
    v_mov_b32 v21, 2
    s_mov_b64 exec, 1
    ds_write_b32 v20, v21
    s_mov_b64 exec, -1
    s_addk_i32 m0, 1024
    s_xor_b32 s96, s62, 8192
    s_waitcnt vmcnt(4)
    buffer_load_dwordx4 v14, s[4:7], s96 offen nt lds
    s_addk_i32 m0, 1024
    s_xor_b32 s96, s62, 16384
    s_waitcnt vmcnt(4)
    buffer_load_dwordx4 v15, s[4:7], s96 offen nt lds
    s_addk_i32 m0, 1024
    s_xor_b32 s96, s62, 24576
    s_waitcnt vmcnt(4)
    buffer_load_dwordx4 v16, s[4:7], s96 offen nt lds
    s_add_u32 m0, s58, 16384
    s_xor_b32 s96, s62, 1024
    s_waitcnt vmcnt(4)
    buffer_load_dwordx4 v13, s[4:7], s96 offen nt lds
    v_mov_b32 v21, 3
    s_mov_b64 exec, 1
    ds_write_b32 v20, v21
    s_mov_b64 exec, -1
    s_addk_i32 m0, 1024
    s_xor_b32 s96, s62, 9216
    s_waitcnt vmcnt(4)
    buffer_load_dwordx4 v14, s[4:7], s96 offen nt lds
    s_addk_i32 m0, 1024
    s_xor_b32 s96, s62, 17408
    s_waitcnt vmcnt(4)
    buffer_load_dwordx4 v15, s[4:7], s96 offen nt lds
    s_addk_i32 m0, 1024
    s_xor_b32 s96, s62, 25600
    s_waitcnt vmcnt(4)
    buffer_load_dwordx4 v16, s[4:7], s96 offen nt lds
    s_add_u32 m0, s58, 32768
    s_xor_b32 s96, s62, 524288
    s_waitcnt vmcnt(4)
    buffer_load_dwordx4 v13, s[4:7], s96 offen nt lds
    s_addk_i32 m0, 1024
    s_xor_b32 s96, s62, 532480
    s_waitcnt vmcnt(4)
    buffer_load_dwordx4 v14, s[4:7], s96 offen nt lds
    s_addk_i32 m0, 1024
    s_xor_b32 s96, s62, 540672
    s_waitcnt vmcnt(4)
    buffer_load_dwordx4 v15, s[4:7], s96 offen nt lds
    s_addk_i32 m0, 1024
    s_xor_b32 s96, s62, 548864
    s_waitcnt vmcnt(4)
    buffer_load_dwordx4 v16, s[4:7], s96 offen nt lds
    s_add_u32 m0, s58, 49152
    s_xor_b32 s96, s62, 525312
    s_waitcnt vmcnt(4)
    buffer_load_dwordx4 v13, s[4:7], s96 offen nt lds
    s_addk_i32 m0, 1024
    s_xor_b32 s96, s62, 533504
    s_waitcnt vmcnt(4)
    buffer_load_dwordx4 v14, s[4:7], s96 offen nt lds
    s_addk_i32 m0, 1024
    s_xor_b32 s96, s62, 541696
    s_waitcnt vmcnt(4)
    buffer_load_dwordx4 v15, s[4:7], s96 offen nt lds
    s_addk_i32 m0, 1024
    s_xor_b32 s96, s62, 549888
    s_waitcnt vmcnt(4)
    buffer_load_dwordx4 v16, s[4:7], s96 offen nt lds
    s_add_u32 m0, s58, 65536
    s_xor_b32 s96, s62, 0
    s_waitcnt vmcnt(4)
    buffer_load_dwordx4 v17, s[8:11], s96 offen nt lds
    s_addk_i32 m0, 1024
    s_xor_b32 s96, s62, 8192
    s_waitcnt vmcnt(4)
    buffer_load_dwordx4 v18, s[8:11], s96 offen nt lds
    s_addk_i32 m0, 1024
    s_xor_b32 s96, s62, 16384
    s_waitcnt vmcnt(4)
    buffer_load_dwordx4 v17, s[8:11], s96 offen nt lds
    s_addk_i32 m0, 1024
    s_xor_b32 s96, s62, 24576
    s_waitcnt vmcnt(4)
    buffer_load_dwordx4 v18, s[8:11], s96 offen nt lds
    s_add_u32 m0, s58, 81920
    s_xor_b32 s96, s62, 1024
    s_waitcnt vmcnt(4)
    buffer_load_dwordx4 v17, s[8:11], s96 offen nt lds
    v_mov_b32 v21, 4
    s_mov_b64 exec, 1
    ds_write_b32 v20, v21
    s_mov_b64 exec, -1
    s_addk_i32 m0, 1024
    s_xor_b32 s96, s62, 9216
    s_waitcnt vmcnt(4)
    buffer_load_dwordx4 v18, s[8:11], s96 offen nt lds
    ds_read_b32 v23, v22
    s_addk_i32 m0, 1024
    s_xor_b32 s96, s62, 17408
    s_waitcnt vmcnt(4)
    buffer_load_dwordx4 v17, s[8:11], s96 offen nt lds
    s_addk_i32 m0, 1024
    s_xor_b32 s96, s62, 25600
    s_waitcnt vmcnt(4)
    buffer_load_dwordx4 v18, s[8:11], s96 offen nt lds
    s_waitcnt lgkmcnt(0)
    v_cmp_gt_u32 vcc, 2, v23
    s_nop 0
    s_and_b64 vcc, vcc, 0xff0
    s_cbranch_vccz Lew1
Lw2:
    ds_read_b32 v23, v22
    s_waitcnt lgkmcnt(0)
    v_cmp_gt_u32 vcc, 2, v23
    s_nop 0
    s_and_b64 vcc, vcc, 0xff0
    s_cbranch_vccnz Lw2
Lew1:
    s_add_u32 m0, s58, 98304
    s_xor_b32 s96, s62, 524288
    s_waitcnt vmcnt(4)
    buffer_load_dwordx4 v17, s[8:11], s96 offen nt lds
    v_mov_b32 v21, 5
    s_mov_b64 exec, 1
    ds_write_b32 v20, v21
    s_mov_b64 exec, -1
    s_addk_i32 m0, 1024
    s_xor_b32 s96, s62, 532480
    s_waitcnt vmcnt(4)
    buffer_load_dwordx4 v18, s[8:11], s96 offen nt lds
    s_addk_i32 m0, 1024
    s_xor_b32 s96, s62, 540672
    s_waitcnt vmcnt(4)
    buffer_load_dwordx4 v17, s[8:11], s96 offen nt lds
    s_addk_i32 m0, 1024
    s_xor_b32 s96, s62, 548864
    s_waitcnt vmcnt(4)
    buffer_load_dwordx4 v18, s[8:11], s96 offen nt lds
    s_add_u32 m0, s58, 114688
    s_xor_b32 s96, s62, 525312
    s_waitcnt vmcnt(4)
    buffer_load_dwordx4 v17, s[8:11], s96 offen nt lds
    v_mov_b32 v21, 6
    s_mov_b64 exec, 1
    ds_write_b32 v20, v21
    s_mov_b64 exec, -1
    s_addk_i32 m0, 1024
    s_xor_b32 s96, s62, 533504
    s_waitcnt vmcnt(4)
    buffer_load_dwordx4 v18, s[8:11], s96 offen nt lds
    s_addk_i32 m0, 1024
    s_xor_b32 s96, s62, 541696
    s_waitcnt vmcnt(4)
    buffer_load_dwordx4 v17, s[8:11], s96 offen nt lds
    s_addk_i32 m0, 1024
    s_xor_b32 s96, s62, 549888
    s_waitcnt vmcnt(4)
    buffer_load_dwordx4 v18, s[8:11], s96 offen nt lds
    s_add_u32 m0, s61, 147456
    s_waitcnt vmcnt(4)
    buffer_load_dwordx4 v12, s[28:31], s60 offen nt lds
    v_mov_b32 v21, 7
    s_mov_b64 exec, 1
    ds_write_b32 v20, v21
    s_mov_b64 exec, -1
    s_add_u32 m0, s61, 151552
    s_add_u32 s46, s60, 32768
    s_waitcnt vmcnt(4)
    buffer_load_dwordx4 v12, s[28:31], s46 offen nt lds
    s_add_u32 m0, s61, 131072
    s_waitcnt vmcnt(4)
    buffer_load_dwordx4 v12, s[16:19], s63 offen nt lds
    s_add_u32 m0, s61, 135168
    s_add_u32 s46, s63, 32768
    s_waitcnt vmcnt(4)
    buffer_load_dwordx4 v12, s[16:19], s46 offen nt lds
    s_waitcnt vmcnt(4)
    s_barrier
    s_barrier
    s_add_u32 m0, s61, 139264
    s_add_u32 s46, s63, 65536
    buffer_load_dwordx4 v12, s[16:19], s46 offen nt lds
    s_add_u32 m0, s61, 143360
    s_add_u32 s46, s63, 98304
    buffer_load_dwordx4 v12, s[16:19], s46 offen nt lds
    s_waitcnt vmcnt(4)
    v_mov_b32 v21, 8
    s_mov_b64 exec, 1
    ds_write_b32 v20, v21
    s_mov_b64 exec, -1
    s_waitcnt vmcnt(0)
    v_mov_b32 v21, 12
    s_mov_b64 exec, 1
    ds_write_b32 v20, v21
    s_mov_b64 exec, -1
    s_endpgm
L_compute:
    s_load_dwordx2 s[32:33], s[0:1], 88
    s_load_dwordx4 s[40:43], s[0:1], 72
    v_lshlrev_b32 v7, 4, v0
    s_sub_u32 s55, s3, 4
    s_cmp_lg_u32 s55, 7
    s_cbranch_scc1 L_nopf
    s_getpc_b64 s[60:61]
L_pc:
    s_sub_u32 s60, s60, L_pc-recurrent_scan__sliding_block_cached__glu_gated_glu__decode_kernel
    s_subb_u32 s61, s61, 0
    s_lshl_b32 s58, s51, 10
    v_add_u32 v122, s58, v7
    v_cmp_gt_u32 vcc, L_codeend-recurrent_scan__sliding_block_cached__glu_gated_glu__decode_kernel-15, v122
    s_nop 0
    s_and_saveexec_b64 s[58:59], vcc
    s_cbranch_execz L_nopf2
    global_load_dwordx4 v[112:115], v122, s[60:61]
L_nopf2:
    s_mov_b64 exec, -1
    v_add_u32 v122, 8192, v122
    v_cmp_gt_u32 vcc, L_codeend-recurrent_scan__sliding_block_cached__glu_gated_glu__decode_kernel-15, v122
    s_nop 0
    s_and_saveexec_b64 s[58:59], vcc
    s_cbranch_execz L_nopf3
    global_load_dwordx4 v[116:119], v122, s[60:61]
L_nopf3:
    s_mov_b64 exec, -1
L_nopf:
    s_barrier
    s_setprio 2
    s_mov_b32 s38, 2048
    s_mov_b32 s39, 0x20000
    s_mov_b32 s34, 134217728
    s_mov_b32 s35, 0x20000
    s_lshr_b32 s53, s50, 4
    s_and_b32 s54, s50, 15
    s_waitcnt lgkmcnt(0)
    s_mov_b64 s[24:25], s[42:43]
    s_movk_i32 s26, 256
    s_mov_b32 s27, s39
    s_movk_i32 s42, 2048
    s_mov_b32 s43, s39
    s_load_dword s44, s[32:33], 0
    v_and_b32 v1, 15, v0
    v_lshrrev_b32 v2, 4, v0
    v_and_b32 v120, 7, v0
    v_lshrrev_b32 v119, 5, v0
    v_lshlrev_b32 v119, 10, v119
    v_lshl_add_u32 v120, v120, 1, v119
    s_bfe_u32 s30, s2, 0x10006
    s_and_b32 s29, s2, 3
    s_lshl2_add_u32 s30, s30, s29
    s_bfe_u32 s29, s2, 0x30003
    s_lshl3_add_u32 s30, s30, s29
    s_and_b32 s29, s2, 0x84
    s_xor_b32 s29, s29, 0
    s_mov_b32 s22, s29
    s_lshr_b32 s56, s30, 1
    s_lshl_b32 s56, s56, 2
    s_and_b32 s58, s30, 1
    s_or_b32 s56, s56, s58
    s_lshl_b32 s56, s56, 12
    s_add_u32 s28, s56, 1048576
    s_cmp_lg_u32 s55, 4
    s_cbranch_scc1 L_noxr
    s_cmp_lg_u32 s29, 0
    s_cbranch_scc1 L_noxr
    s_lshl_b32 s31, s30, 4
    buffer_load_ushort v121, v120, s[36:39], s31 offen
    v_mov_b32 v119, 0
    s_mov_b32 exec_lo, 0xff
    s_mov_b32 exec_hi, 0xff
    buffer_store_short v119, v120, s[40:43], s31 offen
    s_mov_b64 exec, -1
    s_add_u32 s56, s28, 8192
    v_lshlrev_b32 v118, 6, v0
L_noxr:
    s_cmp_lg_u32 s55, 6
    s_cbranch_scc1 L_nosp
    s_and_b32 s56, s2, 4
    s_cbranch_scc1 L_nosp
    v_lshlrev_b32 v118, 6, v0
    s_lshr_b32 s56, s2, 7
    s_lshl_b32 s56, s56, 13
    s_add_u32 s56, s56, s28
    buffer_load_dword v119, v118, s[32:35], s56 offen sc1
L_nosp:
    v_lshlrev_b32 v4, 2, v1
    v_add_u32 v4, 155648, v4
    s_lshl_b32 s56, s55, 2
    s_add_u32 s56, s56, 155664
    v_mov_b32 v6, s56
    v_mov_b32 v3, 0xffffff00
    s_lshl_b32 s62, s49, 2
    s_add_u32 s62, s62, s52
    s_and_b32 s56, s55, 3
    v_lshrrev_b32 v8, 2, v1
    v_lshl_add_u32 v8, v2, 2, v8
    v_bfe_u32 v9, v8, 1, 2
    v_xor_b32 v9, s56, v9
    v_lshlrev_b32 v9, 5, v9
    v_and_b32 v10, 3, v1
    v_lshlrev_b32 v11, 3, v10
    v_add_u32 v9, v9, v11
    v_lshl_add_u32 v15, v8, 7, v9
    v_and_b32 v10, 1, v1
    v_mul_u32_u24 v12, 1088, v10
    v_lshl_add_u32 v12, v2, 3, v12
    s_lshl_b32 s57, s49, 14
    s_lshl_b32 s58, s52, 11
    s_add_u32 s57, s57, s58
    s_lshl_b32 s58, s51, 8
    s_add_u32 s57, s57, s58
    s_add_u32 s57, s57, 65536
    s_lshl_b32 s58, s62, 13
    s_lshl_b32 s59, s51, 10
    s_add_u32 s58, s58, s59
    s_add_u32 s58, s58, 196608
    s_lshl_b32 s59, s52, 8
    s_lshl_b32 s60, s51, 7
    s_cmp_lt_u32 s55, 4
    s_cselect_b32 s57, s57, s58
    s_cselect_b32 s59, s59, s60
    s_mov_b32 s60, 98304
    s_cselect_b32 s60, s60, 114688
    s_cselect_b32 s61, 13, 8
    s_mov_b32 s63, 0x00030003
    s_cselect_b32 s63, s63, 0x000f000f
    s_lshl_b32 s56, s56, 6
    s_add_u32 s57, s57, s56
    s_add_u32 s59, s59, 158208
    v_add_u32 v12, s59, v12
    v_add_u32 v9, s60, v15
    v_lshlrev_b32 v13, s61, v1
    v_lshl_add_u32 v13, v2, 4, v13
    s_cmp_ge_u32 s55, 2
    s_cbranch_scc1 L_noln
    s_mul_i32 s56, s55, 1088
    s_add_u32 s56, s56, 158208
    v_add_u32 v14, s56, v7
Lw3:
    ds_read_b32 v5, v4
    s_waitcnt lgkmcnt(0)
    v_cmp_gt_u32 vcc, 1, v5
    s_nop 0
    s_and_b64 vcc, vcc, 0xf
    s_cbranch_vccnz Lw3
    ds_read_b128 v[16:19], v14
    s_waitcnt lgkmcnt(0)
    v_lshlrev_b32 v20, 16, v16
    v_and_b32 v21, 0xffff0000, v16
    v_lshlrev_b32 v22, 16, v17
    v_and_b32 v23, 0xffff0000, v17
    v_lshlrev_b32 v24, 16, v18
    v_and_b32 v25, 0xffff0000, v18
    v_lshlrev_b32 v26, 16, v19
    v_and_b32 v27, 0xffff0000, v19
    v_add_f32 v28, v20, v21
    v_add_f32 v29, v22, v23
    v_add_f32 v30, v24, v25
    v_add_f32 v31, v26, v27
    v_add_f32 v28, v28, v29
    v_add_f32 v30, v30, v31
    v_add_f32 v28, v28, v30
    s_nop 1
    v_add_f32_dpp v28, v28, v28 quad_perm:[1,0,3,2] row_mask:0xf bank_mask:0xf
    s_nop 1
    v_add_f32_dpp v28, v28, v28 quad_perm:[2,3,0,1] row_mask:0xf bank_mask:0xf
    s_nop 1
    v_add_f32_dpp v28, v28, v28 row_half_mirror row_mask:0xf bank_mask:0xf
    s_nop 1
    v_add_f32_dpp v28, v28, v28 row_mirror row_mask:0xf bank_mask:0xf
    v_mov_b32 v29, v28
    s_nop 1
    v_permlane16_swap_b32 v28, v29
    v_add_f32 v28, v28, v29
    v_mov_b32 v29, v28
    s_nop 1
    v_permlane32_swap_b32 v28, v29
    v_add_f32 v28, v28, v29
    v_mul_f32 v28, 0x3b000000, v28
    v_sub_f32 v32, v20, v28
    v_sub_f32 v33, v21, v28
    v_sub_f32 v34, v22, v28
    v_sub_f32 v35, v23, v28
    v_sub_f32 v36, v24, v28
    v_sub_f32 v37, v25, v28
    v_sub_f32 v38, v26, v28
    v_sub_f32 v39, v27, v28
    v_mul_f32 v29, v32, v32
    v_mul_f32 v30, v33, v33
    v_fmac_f32 v29, v34, v34
    v_fmac_f32 v30, v35, v35
    v_fmac_f32 v29, v36, v36
    v_fmac_f32 v30, v37, v37
    v_fmac_f32 v29, v38, v38
    v_fmac_f32 v30, v39, v39
    v_add_f32 v29, v29, v30
    v_cvt_pk_bf16_f32 v28, 0, v28
    v_sub_f32 v32, v20, v28
    v_sub_f32 v33, v21, v28
    v_sub_f32 v34, v22, v28
    v_sub_f32 v35, v23, v28
    v_sub_f32 v36, v24, v28
    v_sub_f32 v37, v25, v28
    v_sub_f32 v38, v26, v28
    v_sub_f32 v39, v27, v28
    v_add_f32_dpp v29, v29, v29 quad_perm:[1,0,3,2] row_mask:0xf bank_mask:0xf
    s_nop 1
    v_add_f32_dpp v29, v29, v29 quad_perm:[2,3,0,1] row_mask:0xf bank_mask:0xf
    s_nop 1
    v_add_f32_dpp v29, v29, v29 row_half_mirror row_mask:0xf bank_mask:0xf
    s_nop 1
    v_add_f32_dpp v29, v29, v29 row_mirror row_mask:0xf bank_mask:0xf
    v_mov_b32 v30, v29
    s_nop 1
    v_permlane16_swap_b32 v29, v30
    v_add_f32 v29, v29, v30
    v_mov_b32 v30, v29
    s_nop 1
    v_permlane32_swap_b32 v29, v30
    v_add_f32 v29, v29, v30
    v_cvt_pk_bf16_f32 v16, v32, v33
    v_cvt_pk_bf16_f32 v17, v34, v35
    v_cvt_pk_bf16_f32 v18, v36, v37
    v_cvt_pk_bf16_f32 v19, v38, v39
    v_mul_f32 v29, 0x3b000000, v29
    v_cvt_pk_bf16_f32 v29, 0, v29
    v_add_f32 v29, 0x3727c5ac, v29
    v_cvt_pk_bf16_f32 v29, 0, v29
    v_sqrt_f32 v29, v29
    v_lshlrev_b32 v32, 16, v16
    v_and_b32 v33, 0xffff0000, v16
    v_lshlrev_b32 v34, 16, v17
    v_and_b32 v35, 0xffff0000, v17
    v_lshlrev_b32 v36, 16, v18
    v_and_b32 v37, 0xffff0000, v18
    v_lshlrev_b32 v38, 16, v19
    v_and_b32 v39, 0xffff0000, v19
    v_cvt_pk_bf16_f32 v29, 0, v29
    v_rcp_f32 v29, v29
    s_nop 0
    v_mul_f32 v32, v32, v29
    v_mul_f32 v33, v33, v29
    v_mul_f32 v34, v34, v29
    v_mul_f32 v35, v35, v29
    v_mul_f32 v36, v36, v29
    v_mul_f32 v37, v37, v29
    v_mul_f32 v38, v38, v29
    v_mul_f32 v39, v39, v29
    v_cvt_pk_bf16_f32 v16, v32, v33
    v_cvt_pk_bf16_f32 v17, v34, v35
    v_cvt_pk_bf16_f32 v18, v36, v37
    v_cvt_pk_bf16_f32 v19, v38, v39
    ds_write_b128 v14, v[16:19]
    v_mov_b32 v5, 1
    s_mov_b64 exec, 1
    ds_write_b32 v6, v5
    s_mov_b64 exec, -1
L_noln:
    s_waitcnt lgkmcnt(0)
    s_add_u32 s44, s44, 0x01010101
    s_and_b32 s45, s44, 0xff
    s_bfe_u32 s46, s44, 0x80008
    s_bfe_u32 s47, s44, 0x80010
    s_lshr_b32 s48, s44, 24
    s_getreg_b32 s96, hwreg(HW_REG_XCC_ID, 0, 4)
    s_xor_b32 s96, s96, s48
    s_mov_b32 s97, s96
    s_mov_b32 s98, 0
    s_mov_b32 s101, -1
    s_mov_b32 s95, 0
    s_add_u32 s58, s57, 2097152
    v_and_b32 v10, 2, v1
    v_cmp_ne_u32 s[60:61], 0, v10
Lw4:
    ds_read_b32 v5, v4
    s_waitcnt lgkmcnt(0)
    v_cmp_gt_u32 vcc, 1, v5
    s_nop 0
    s_and_b64 vcc, vcc, 0x30
    s_cbranch_vccnz Lw4
    s_cmp_ge_u32 s55, 4
    s_cbranch_scc1 L_gu
    ds_read2_b64 v[32:35], v12 offset0:0 offset1:4
    ds_read2_b64 v[36:39], v12 offset0:8 offset1:12
    ds_read2_b64 v[40:43], v12 offset0:16 offset1:20
    ds_read2_b64 v[44:47], v12 offset0:24 offset1:28
Lw5:
    ds_read_b32 v5, v4
    s_waitcnt lgkmcnt(0)
    v_cmp_gt_u32 vcc, 2, v5
    s_nop 0
    s_and_b64 vcc, vcc, 0xf
    s_cbranch_vccnz Lw5
    ds_read_b64_tr_b16 v[16:17], v9 offset:0
    ds_read_b64_tr_b16 v[18:19], v9 offset:2048
    ds_read_b64_tr_b16 v[20:21], v9 offset:4096
    ds_read_b64_tr_b16 v[22:23], v9 offset:6144
    ds_read_b64_tr_b16 v[24:25], v9 offset:8192
    ds_read_b64_tr_b16 v[26:27], v9 offset:10240
    ds_read_b64_tr_b16 v[28:29], v9 offset:12288
    ds_read_b64_tr_b16 v[30:31], v9 offset:14336
    v_mov_b32 v5, 2
    s_mov_b64 exec, 1
    ds_write_b32 v6, v5
    s_mov_b64 exec, -1
    s_waitcnt lgkmcnt(0)
    v_mfma_f32_16x16x32_bf16 v[48:51], v[16:19], v[32:35], 0
    v_mfma_f32_16x16x32_bf16 v[48:51], v[20:23], v[36:39], v[48:51]
    v_mfma_f32_16x16x32_bf16 v[48:51], v[24:27], v[40:43], v[48:51]
    v_mfma_f32_16x16x32_bf16 v[48:51], v[28:31], v[44:47], v[48:51]
    s_branch L_pub1
L_gu:
    ds_read2_b64 v[32:35], v12 offset0:0 offset1:4
    ds_read2_b64 v[36:39], v12 offset0:8 offset1:12
Lw6:
    ds_read_b32 v5, v4
    s_waitcnt lgkmcnt(0)
    v_cmp_gt_u32 vcc, 3, v5
    s_nop 0
    s_and_b64 vcc, vcc, 0xf
    s_cbranch_vccnz Lw6
    ds_read_b64_tr_b16 v[16:17], v9 offset:0
    ds_read_b64_tr_b16 v[18:19], v9 offset:2048
    ds_read_b64_tr_b16 v[20:21], v9 offset:4096
    ds_read_b64_tr_b16 v[22:23], v9 offset:6144
    ds_read_b64_tr_b16 v[24:25], v9 offset:8192
    ds_read_b64_tr_b16 v[26:27], v9 offset:10240
    ds_read_b64_tr_b16 v[28:29], v9 offset:12288
    ds_read_b64_tr_b16 v[30:31], v9 offset:14336
    v_mov_b32 v5, 2
    s_mov_b64 exec, 1
    ds_write_b32 v6, v5
    s_mov_b64 exec, -1
    s_waitcnt lgkmcnt(0)
    v_mfma_f32_16x16x32_bf16 v[48:51], v[16:19], v[32:35], 0
    v_mfma_f32_16x16x32_bf16 v[56:59], v[24:27], v[32:35], 0
    v_mfma_f32_16x16x32_bf16 v[48:51], v[20:23], v[36:39], v[48:51]
    v_mfma_f32_16x16x32_bf16 v[56:59], v[28:31], v[36:39], v[56:59]
    s_nop 7
    v_cndmask_b32 v48, v48, v56, s[60:61]
    v_cndmask_b32 v49, v49, v57, s[60:61]
    v_cndmask_b32 v50, v50, v58, s[60:61]
    v_cndmask_b32 v51, v51, v59, s[60:61]
L_pub1:
    s_nop 7
    v_and_or_b32 v52, v48, v3, s45
    v_and_or_b32 v53, v49, v3, s46
    v_and_or_b32 v54, v50, v3, s47
    v_and_or_b32 v55, v51, v3, s96
    s_mov_b32 exec_lo, s63
    s_mov_b32 exec_hi, s63
    buffer_store_dwordx4 v[52:55], v13, s[32:35], s57 offen
    s_mov_b64 exec, -1
    s_cmp_lt_u32 s55, 4
    s_cbranch_scc1 L_noprobe
    s_cmp_lg_u32 s2, 128
    s_cbranch_scc1 L_noprobe
    s_mov_b32 s4, s55
    s_lshl_b32 s4, s4, 7
    s_and_b32 s5, s55, 1
    s_lshl_b32 s5, s5, 13
    s_add_u32 s4, s4, s5
    s_add_u32 s4, s4, 1572864
    s_xor_b32 s5, s4, 0x2000
    s_add_u32 s6, s32, s4
    s_addc_u32 s7, s33, 0
    s_add_u32 s8, s32, s5
    s_addc_u32 s9, s33, 0
    s_load_dword s10, s[6:7], 0 glc
    s_load_dword s11, s[8:9], 0 glc
    s_mov_b32 s16, 0
    s_waitcnt lgkmcnt(0)
    s_memtime s[12:13]
    s_waitcnt lgkmcnt(0)
    s_load_dword s10, s[6:7], 0 glc
    s_waitcnt lgkmcnt(0)
    s_memtime s[14:15]
    s_waitcnt lgkmcnt(0)
    s_load_dword s10, s[8:9], 0 glc
    s_waitcnt lgkmcnt(0)
    s_memtime s[18:19]
    s_waitcnt lgkmcnt(0)
    s_lshl_b32 s14, s14, 1
    s_sub_u32 s14, s14, s12
    s_sub_u32 s14, s14, s18
    s_add_u32 s16, s16, s14
    s_sub_u32 s14, 0, s16
    s_bitcmp1_b32 s55, 0
    s_cselect_b32 s16, s14, s16
    s_min_i32 s16, s16, 2047
    s_max_i32 s16, s16, -2047
    s_add_u32 s16, s16, 1050624
    v_mov_b32 v5, s16
    s_mov_b64 exec, 1
    ds_add_rtn_u32 v16, v4, v5 offset:60
    s_waitcnt lgkmcnt(0)
    v_readfirstlane_b32 s14, v16
    s_nop 0
    s_add_u32 s14, s14, s16
    s_lshr_b32 s15, s14, 20
    s_cmp_lg_u32 s15, 4
    s_cbranch_scc1 L_noprobe2
    s_and_b32 s14, s14, 0xfffff
    s_cmp_gt_u32 s14, 8192
    s_cselect_b32 s14, 2, 1
    v_mov_b32 v16, s14
    v_mov_b32 v17, 0
    buffer_store_dword v16, v17, s[24:27], 0 offen sc1
L_noprobe2:
    s_mov_b64 exec, -1
L_noprobe:
    v_and_b32 v10, 3, v1
    v_mul_u32_u24 v9, 320, v10
    v_lshl_add_u32 v9, v2, 4, v9
    v_add_u32 v9, 156928, v9
    s_lshl_b32 s56, s55, 13
    v_xor_b32 v12, v1, v2
    v_lshlrev_b32 v12, 4, v12
    v_lshl_add_u32 v12, v1, 8, v12
    v_add_u32 v12, s56, v12
    v_xor_b32 v62, 64, v12
    v_xor_b32 v63, 128, v12
    v_xor_b32 v64, 192, v12
    s_cmp_ge_u32 s55, 2
    s_cbranch_scc1 L_noq
    s_lshl_b32 s56, s55, 10
    v_add_u32 v126, s56, v7
    s_lshl_b32 s99, s49, 14
    s_lshl_b32 s100, s53, 13
    s_add_u32 s99, s99, s100
    s_add_u32 s99, s99, 65536
    s_add_u32 s100, s99, 4096
    s_lshl_b32 s56, s55, 1
    v_lshrrev_b32 v14, 5, v0
    v_add_u32 v14, s56, v14
    v_mul_u32_u24 v14, 320, v14
    v_and_b32 v16, 31, v0
    v_lshl_add_u32 v14, v16, 3, v14
    v_add_u32 v14, 156928, v14
Lw7:
    ds_read_b32 v5, v4
    s_waitcnt lgkmcnt(0)
    v_cmp_gt_u32 vcc, 3, v5
    s_nop 0
    s_and_b64 vcc, vcc, 0xf
    s_cbranch_vccnz Lw7
    s_mov_b32 s59, 0
Lp8:
    s_add_u32 s59, s59, 1
    s_cmp_lt_u32 s59, 64
    s_cbranch_scc1 Lqe11
    v_mov_b32 v5, 1
    s_mov_b64 exec, 1
    ds_write_b32 v4, v5 offset:56
    s_mov_b64 exec, -1
    s_cmp_lg_u32 s95, 0
    s_cbranch_scc1 Lff12
    s_mov_b32 s95, 1
    s_mov_b32 exec_lo, s63
    s_mov_b32 exec_hi, s63
    buffer_store_dwordx4 v[52:55], v13, s[32:35], s58 offen sc1
    s_mov_b64 exec, -1
Lff12:
    s_xor_b32 s98, s98, 2097152
    s_xor_b32 s99, s99, 2097152
    s_xor_b32 s100, s100, 2097152
    s_xor_b32 s101, s101, 15
Lqe11:
    buffer_load_dwordx4 v[16:19], v126, s[32:35], s99 offen offset:0 sc1
    buffer_load_dwordx4 v[20:23], v126, s[32:35], s99 offen offset:2048 sc1
    buffer_load_dwordx4 v[24:27], v126, s[32:35], s100 offen offset:0 sc1
    buffer_load_dwordx4 v[28:31], v126, s[32:35], s100 offen offset:2048 sc1
    s_waitcnt vmcnt(0)
Lpc9:
    v_xor_b32 v16, s45, v16
    v_xor_b32 v17, s46, v17
    v_xor_b32 v18, s47, v18
    v_xor_b32 v19, s96, v19
    v_or3_b32 v5, v16, v17, v18
    v_mov_b32 v127, v19
    v_xor_b32 v20, s45, v20
    v_xor_b32 v21, s46, v21
    v_xor_b32 v22, s47, v22
    v_xor_b32 v23, s96, v23
    v_or3_b32 v5, v5, v20, v21
    v_or_b32 v5, v5, v22
    v_or_b32 v127, v127, v23
    v_xor_b32 v24, s45, v24
    v_xor_b32 v25, s46, v25
    v_xor_b32 v26, s47, v26
    v_xor_b32 v27, s96, v27
    v_or3_b32 v5, v5, v24, v25
    v_or_b32 v5, v5, v26
    v_or_b32 v127, v127, v27
    v_xor_b32 v28, s45, v28
    v_xor_b32 v29, s46, v29
    v_xor_b32 v30, s47, v30
    v_xor_b32 v31, s96, v31
    v_or3_b32 v5, v5, v28, v29
    v_or_b32 v5, v5, v30
    v_or_b32 v127, v127, v31
    v_and_or_b32 v5, v127, s101, v5
    v_and_b32 v5, 0xff, v5
    v_cmp_ne_u32 vcc, 0, v5
    s_nop 0
    s_cbranch_vccz Lpd10
    s_cmp_lt_u32 s59, 400000
    s_cbranch_scc1 Lp8
Lpd10:
    v_and_b32 v127, 15, v127
    v_cmp_ne_u32 vcc, 0, v127
    s_nop 0
    s_cbranch_vccnz L_remote
    s_mov_b32 s98, 0
L_remote:
    v_and_b32 v19, v19, v3
    v_and_b32 v23, v23, v3
    v_and_b32 v27, v27, v3
    v_and_b32 v31, v31, v3
    v_add_f32 v16, v16, v20
    v_add_f32 v24, v24, v28
    v_add_f32 v17, v17, v21
    v_add_f32 v25, v25, v29
    v_add_f32 v18, v18, v22
    v_add_f32 v26, v26, v30
    v_add_f32 v19, v19, v23
    v_add_f32 v27, v27, v31
    v_add_f32 v16, v16, v24
    v_add_f32 v17, v17, v25
    v_add_f32 v18, v18, v26
    v_add_f32 v19, v19, v27
    v_cvt_pk_bf16_f32 v20, v16, v17
    v_cvt_pk_bf16_f32 v21, v18, v19
    ds_write_b64 v14, v[20:21]
    v_mov_b32 v5, s98
    s_mov_b64 exec, 1
    ds_write_b32 v6, v5 offset:32
    s_mov_b64 exec, -1
    v_mov_b32 v5, 3
    s_mov_b64 exec, 1
    ds_write_b32 v6, v5
    s_mov_b64 exec, -1
L_noq:
Lw13:
    ds_read_b32 v5, v4
    s_waitcnt lgkmcnt(0)
    v_cmp_ne_u32 vcc, 0, v5
    s_nop 0
    s_and_b64 vcc, vcc, 0x4000
    s_cbranch_vccz Lwt14
    s_cmp_lg_u32 s95, 0
    s_cbranch_scc1 Lff15
    s_mov_b32 s95, 1
    s_mov_b32 exec_lo, s63
    s_mov_b32 exec_hi, s63
    buffer_store_dwordx4 v[52:55], v13, s[32:35], s58 offen sc1
    s_mov_b64 exec, -1
Lff15:
Lwt14:
    v_cmp_gt_u32 vcc, 3, v5
    s_nop 0
    s_and_b64 vcc, vcc, 0x30
    s_cbranch_vccnz Lw13
    v_cmp_ne_u32 vcc, 0, v5
    s_nop 0
    s_and_b64 vcc, vcc, 0x3000
    s_mov_b32 s98, 0
    s_mov_b32 s101, -1
    s_cbranch_vccz L_near
    s_mov_b32 s98, 2097152
    s_mov_b32 s97, s48
    s_mov_b32 s101, 0xfffffff0
    s_cmp_lg_u32 s95, 0
    s_cbranch_scc1 Lff16
    s_mov_b32 s95, 1
    s_mov_b32 exec_lo, s63
    s_mov_b32 exec_hi, s63
    buffer_store_dwordx4 v[52:55], v13, s[32:35], s58 offen sc1
    s_mov_b64 exec, -1
Lff16:
L_near:
    ds_read_b128 v[16:19], v9 offset:0
    ds_read_b128 v[20:23], v9 offset:64
    ds_read_b128 v[24:27], v9 offset:128
    ds_read_b128 v[28:31], v9 offset:192
Lw17:
    ds_read_b32 v5, v4
    s_waitcnt lgkmcnt(0)
    v_cmp_gt_u32 vcc, 4, v5
    s_nop 0
    s_and_b64 vcc, vcc, 0xf
    s_cbranch_vccnz Lw17
    ds_read_b128 v[32:35], v12 offset:0
    ds_read_b128 v[36:39], v62 offset:0
    ds_read_b128 v[40:43], v63 offset:0
    ds_read_b128 v[44:47], v64 offset:0
    ds_read_b128 v[48:51], v12 offset:4096
    ds_read_b128 v[92:95], v62 offset:4096
    ds_read_b128 v[56:59], v63 offset:4096
    ds_read_b128 v[88:91], v64 offset:4096
    v_lshlrev_b32 v9, 5, v10
    v_add_u32 v9, 155712, v9
    s_lshl_b32 s56, s55, 2
    v_add_u32 v12, s56, v9
    s_lshl_b32 s56, s55, 8
    v_lshlrev_b32 v13, 6, v2
    v_lshl_add_u32 v13, v10, 4, v13
    v_add_u32 v13, 160512, v13
    v_add_u32 v14, s56, v13
    s_waitcnt lgkmcnt(0)
    v_mfma_f32_16x16x32_bf16 v[68:71], v[32:35], v[16:19], 0
    v_mfma_f32_16x16x32_bf16 v[72:75], v[48:51], v[16:19], 0
    v_mfma_f32_16x16x32_bf16 v[68:71], v[36:39], v[20:23], v[68:71]
    v_mfma_f32_16x16x32_bf16 v[72:75], v[92:95], v[20:23], v[72:75]
    v_mfma_f32_16x16x32_bf16 v[68:71], v[40:43], v[24:27], v[68:71]
    v_mfma_f32_16x16x32_bf16 v[72:75], v[56:59], v[24:27], v[72:75]
    v_mfma_f32_16x16x32_bf16 v[68:71], v[44:47], v[28:31], v[68:71]
    v_mfma_f32_16x16x32_bf16 v[72:75], v[88:91], v[28:31], v[72:75]
    s_nop 6
    v_cvt_pk_bf16_f32 v36, 0, v68
    v_cvt_pk_bf16_f32 v37, 0, v69
    v_cvt_pk_bf16_f32 v38, 0, v70
    v_cvt_pk_bf16_f32 v39, 0, v71
    v_cvt_pk_bf16_f32 v40, 0, v72
    v_cvt_pk_bf16_f32 v41, 0, v73
    v_cvt_pk_bf16_f32 v42, 0, v74
    v_cvt_pk_bf16_f32 v43, 0, v75
    v_mul_f32 v36, 0x3db504f3, v36
    v_mul_f32 v37, 0x3db504f3, v37
    v_mul_f32 v38, 0x3db504f3, v38
    v_mul_f32 v39, 0x3db504f3, v39
    v_mul_f32 v40, 0x3db504f3, v40
    v_mul_f32 v41, 0x3db504f3, v41
    v_mul_f32 v42, 0x3db504f3, v42
    v_mul_f32 v43, 0x3db504f3, v43
    v_cvt_pk_bf16_f32 v36, 0, v36
    v_cvt_pk_bf16_f32 v37, 0, v37
    v_cvt_pk_bf16_f32 v38, 0, v38
    v_cvt_pk_bf16_f32 v39, 0, v39
    v_cvt_pk_bf16_f32 v40, 0, v40
    v_cvt_pk_bf16_f32 v41, 0, v41
    v_cvt_pk_bf16_f32 v42, 0, v42
    v_cvt_pk_bf16_f32 v43, 0, v43
    v_max3_f32 v56, v36, v37, v38
    v_max3_f32 v57, v39, v40, v41
    v_max3_f32 v56, v56, v42, v43
    v_max_f32 v56, v56, v57
    v_mov_b32 v57, v56
    s_nop 1
    v_permlane16_swap_b32 v56, v57
    v_max_f32 v56, v56, v57
    v_mov_b32 v57, v56
    s_nop 1
    v_permlane32_swap_b32 v56, v57
    v_max_f32 v56, v56, v57
    s_mov_b64 exec, 15
    ds_write_b32 v12, v56
    v_mov_b32 v5, 4
    s_mov_b64 exec, 1
    ds_write_b32 v6, v5
    s_mov_b64 exec, -1
Lw18:
    ds_read_b32 v5, v4
    s_waitcnt lgkmcnt(0)
    v_cmp_gt_u32 vcc, 4, v5
    s_nop 0
    s_and_b64 vcc, vcc, 0xff0
    s_cbranch_vccnz Lw18
    ds_read_b128 v[44:47], v9
    ds_read_b128 v[48:51], v9 offset:16
    s_mov_b32 s56, 0x3fb8aa3b
    s_waitcnt lgkmcnt(0)
    v_max3_f32 v56, v44, v45, v46
    v_max3_f32 v57, v47, v48, v49
    v_max3_f32 v56, v56, v50, v51
    v_max_f32 v56, v56, v57
    v_mul_f32 v57, s56, v56
    v_fma_f32 v36, v36, s56, -v57
    v_fma_f32 v37, v37, s56, -v57
    v_fma_f32 v38, v38, s56, -v57
    v_fma_f32 v39, v39, s56, -v57
    v_fma_f32 v40, v40, s56, -v57
    v_fma_f32 v41, v41, s56, -v57
    v_fma_f32 v42, v42, s56, -v57
    v_fma_f32 v43, v43, s56, -v57
    v_exp_f32 v36, v36
    v_exp_f32 v37, v37
    v_exp_f32 v38, v38
    v_exp_f32 v39, v39
    v_exp_f32 v40, v40
    v_exp_f32 v41, v41
    v_exp_f32 v42, v42
    v_exp_f32 v43, v43
    v_cvt_pk_bf16_f32 v32, v36, v37
    v_cvt_pk_bf16_f32 v33, v38, v39
    v_cvt_pk_bf16_f32 v34, v40, v41
    v_cvt_pk_bf16_f32 v35, v42, v43
    s_mov_b32 exec_lo, 0xf000f
    s_mov_b32 exec_hi, 0xf000f
    ds_write_b128 v14, v[32:35]
    v_mov_b32 v5, 5
    s_mov_b64 exec, 1
    ds_write_b32 v6, v5
    s_mov_b64 exec, -1
    v_and_b32 v9, 7, v8
    v_xor_b32 v9, s55, v9
    v_lshlrev_b32 v9, 5, v9
    v_add_u32 v9, v9, v11
    v_lshl_add_u32 v9, v8, 8, v9
    v_add_u32 v9, 65536, v9
    v_lshlrev_b32 v12, 14, v1
    v_lshl_add_u32 v12, v2, 4, v12
    s_lshl_b32 s56, s49, 16
    s_lshl_b32 s57, s50, 9
    s_add_u32 s56, s56, s57
    s_lshl_b32 s57, s55, 6
    s_add_u32 s56, s56, s57
    s_add_u32 s56, s56, 524288
    s_add_u32 s56, s56, s98
Lw19:
    ds_read_b32 v5, v4
    s_waitcnt lgkmcnt(0)
    v_cmp_gt_u32 vcc, 5, v5
    s_nop 0
    s_and_b64 vcc, vcc, 0xff0
    s_cbranch_vccnz Lw19
    ds_read_b128 v[16:19], v13 offset:0
    ds_read_b128 v[20:23], v13 offset:256
    ds_read_b128 v[24:27], v13 offset:512
    ds_read_b128 v[28:31], v13 offset:768
    ds_read_b128 v[32:35], v13 offset:1024
    ds_read_b128 v[36:39], v13 offset:1280
    ds_read_b128 v[40:43], v13 offset:1536
    ds_read_b128 v[44:47], v13 offset:1792
    s_waitcnt lgkmcnt(0)
    s_cmp_lg_u32 s55, 3
    s_cbranch_scc1 L_nol
    v_mov_b32 v52, 0x3f803f80
    v_mov_b32 v53, 0x3f803f80
    v_mov_b32 v54, 0x3f803f80
    v_mov_b32 v55, 0x3f803f80
    s_nop 1
    v_mfma_f32_16x16x32_bf16 v[60:63], v[52:55], v[16:19], 0
    v_mfma_f32_16x16x32_bf16 v[60:63], v[52:55], v[20:23], v[60:63]
    v_mfma_f32_16x16x32_bf16 v[60:63], v[52:55], v[24:27], v[60:63]
    v_mfma_f32_16x16x32_bf16 v[60:63], v[52:55], v[28:31], v[60:63]
    v_mfma_f32_16x16x32_bf16 v[60:63], v[52:55], v[32:35], v[60:63]
    v_mfma_f32_16x16x32_bf16 v[60:63], v[52:55], v[36:39], v[60:63]
    v_mfma_f32_16x16x32_bf16 v[60:63], v[52:55], v[40:43], v[60:63]
    v_mfma_f32_16x16x32_bf16 v[60:63], v[52:55], v[44:47], v[60:63]
    v_lshlrev_b32 v13, 9, v0
    s_lshl_b32 s57, s49, 11
    s_lshl_b32 s58, s50, 4
    s_add_u32 s57, s57, s58
    s_add_u32 s57, s57, 458752
    s_add_u32 s57, s57, s98
    v_mov_b32 v58, 0
    v_mov_b32 v59, 0
    v_mov_b32 v57, v60
    v_and_or_b32 v60, v56, v3, s45
    v_and_or_b32 v61, v57, v3, s46
    v_and_or_b32 v62, v58, v3, s47
    v_and_or_b32 v63, v59, v3, s97
    s_mov_b64 exec, 15
    s_cmp_lg_u32 s98, 0
    s_cbranch_scc1 Lms20
    buffer_store_dwordx4 v[60:63], v13, s[32:35], s57 offen
    s_branch Lmd21
Lms20:
    buffer_store_dwordx4 v[60:63], v13, s[32:35], s57 offen sc1
Lmd21:
    s_mov_b64 exec, -1
L_nol:
    v_lshrrev_b32 v10, 3, v0
    v_and_b32 v14, 7, v0
    v_lshlrev_b32 v13, 4, v10
    v_lshlrev_b32 v10, 9, v10
    v_lshl_add_u32 v10, v14, 4, v10
    s_lshr_b32 s60, s55, 2
    s_and_b32 s61, s55, 3
    s_lshl_b32 s58, s62, 1
    s_add_u32 s58, s58, s60
    s_lshl_b32 s57, s58, 8
    s_add_u32 s57, s57, 458752
    s_add_u32 s57, s57, s98
    s_lshl_b32 s58, s58, 13
    s_lshl_b32 s91, s61, 7
    s_add_u32 s58, s58, s91
    s_add_u32 s58, s58, 524288
    s_add_u32 s58, s58, s98
    s_add_u32 s91, s58, 4096
    s_mul_i32 s60, s60, 320
    s_lshl_b32 s61, s61, 6
    s_add_u32 s60, s60, s61
    s_add_u32 s60, s60, 156288
    v_lshrrev_b32 v93, 2, v14
    v_and_b32 v14, 3, v14
    v_lshlrev_b32 v14, 4, v14
    v_lshl_add_u32 v14, v93, 3, v14
    v_lshl_add_u32 v14, v2, 1, v14
    v_add_u32 v14, s60, v14
    v_and_b32 v93, 1, v1
    v_mul_u32_u24 v90, 320, v93
    v_lshl_add_u32 v90, v2, 4, v90
    v_add_u32 v90, 156288, v90
    v_mul_u32_u24 v91, 192, v93
    v_lshl_add_u32 v91, v2, 3, v91
    v_add_u32 v91, 155904, v91
    v_add_u32 v15, 131072, v15
    v_bfe_u32 v93, v0, 3, 1
    v_and_b32 v92, 7, v0
    v_lshlrev_b32 v92, 4, v92
    v_lshl_add_u32 v92, v93, 12, v92
    v_cmp_ne_u32 s[60:61], 0, v93
    s_lshl_b32 s92, s51, 16
    s_lshl_b32 s93, s55, 14
    s_add_u32 s92, s92, s93
    s_lshl_b32 s93, s62, 7
    s_add_u32 s92, s92, s93
    s_add_u32 s92, s92, 1048576
    v_mov_b32 v94, 0
    s_mov_b64 exec, 0xf
    v_mov_b32 v94, 8
    s_mov_b64 exec, -1
    s_cmp_lg_u32 s55, 5
    s_cbranch_scc1 L_noh0
    s_lshl_b32 s99, s62, 13
    s_add_u32 s99, s99, 196608
    s_add_u32 s99, s99, s98
    s_add_u32 s100, s99, 4096
    buffer_load_dwordx4 v[96:99], v7, s[32:35], s99 offen offset:0 sc1
    buffer_load_dwordx4 v[100:103], v7, s[32:35], s99 offen offset:1024 sc1
    buffer_load_dwordx4 v[104:107], v7, s[32:35], s99 offen offset:2048 sc1
    buffer_load_dwordx4 v[108:111], v7, s[32:35], s99 offen offset:3072 sc1
    buffer_load_dwordx4 v[112:115], v7, s[32:35], s100 offen offset:0 sc1
    buffer_load_dwordx4 v[116:119], v7, s[32:35], s100 offen offset:1024 sc1
    buffer_load_dwordx4 v[48:51], v7, s[32:35], s100 offen offset:2048 sc1
    buffer_load_dwordx4 v[52:55], v7, s[32:35], s100 offen offset:3072 sc1
L_noh0:
Lw22:
    ds_read_b32 v5, v4
    s_waitcnt lgkmcnt(0)
    v_cmp_gt_u32 vcc, 5, v5
    s_nop 0
    s_and_b64 vcc, vcc, 0xf
    s_cbranch_vccnz Lw22
    ds_read_b64_tr_b16 v[64:65], v9 offset:0
    ds_read_b64_tr_b16 v[66:67], v9 offset:4096
    ds_read_b64_tr_b16 v[68:69], v9 offset:8192
    ds_read_b64_tr_b16 v[70:71], v9 offset:12288
    s_waitcnt lgkmcnt(2)
    v_mfma_f32_16x16x32_bf16 v[72:75], v[64:67], v[16:19], 0
    s_waitcnt lgkmcnt(0)
    v_mfma_f32_16x16x32_bf16 v[72:75], v[68:71], v[20:23], v[72:75]
Lw23:
    ds_read_b32 v5, v4
    s_waitcnt lgkmcnt(0)
    v_cmp_gt_u32 vcc, 6, v5
    s_nop 0
    s_and_b64 vcc, vcc, 0xf
    s_cbranch_vccnz Lw23
    ds_read_b64_tr_b16 v[64:65], v9 offset:16384
    ds_read_b64_tr_b16 v[66:67], v9 offset:20480
    ds_read_b64_tr_b16 v[68:69], v9 offset:24576
    ds_read_b64_tr_b16 v[70:71], v9 offset:28672
    s_waitcnt lgkmcnt(2)
    v_mfma_f32_16x16x32_bf16 v[72:75], v[64:67], v[24:27], v[72:75]
    s_waitcnt lgkmcnt(0)
    v_mfma_f32_16x16x32_bf16 v[72:75], v[68:71], v[28:31], v[72:75]
    v_mov_b32 v123, 0
    v_mov_b32 v122, 1
    s_cmp_ge_u32 s55, 5
    s_cbranch_scc1 L_nosl
    s_mov_b64 exec, 1
    buffer_load_dword v122, v123, s[24:27], 0 offen sc1
    s_mov_b64 exec, -1
L_nosl:
Lw24:
    ds_read_b32 v5, v4
    s_waitcnt lgkmcnt(0)
    v_cmp_gt_u32 vcc, 7, v5
    s_nop 0
    s_and_b64 vcc, vcc, 0xf
    s_cbranch_vccnz Lw24
    ds_read_b64_tr_b16 v[64:65], v9 offset:32768
    ds_read_b64_tr_b16 v[66:67], v9 offset:36864
    ds_read_b64_tr_b16 v[68:69], v9 offset:40960
    ds_read_b64_tr_b16 v[70:71], v9 offset:45056
    s_waitcnt lgkmcnt(2)
    v_mfma_f32_16x16x32_bf16 v[72:75], v[64:67], v[32:35], v[72:75]
    s_waitcnt lgkmcnt(0)
    v_mfma_f32_16x16x32_bf16 v[72:75], v[68:71], v[36:39], v[72:75]
    buffer_load_dwordx4 v[80:83], v13, s[32:35], s57 offen offset:0 sc1
    buffer_load_dwordx4 v[84:87], v13, s[32:35], s57 offen offset:128 sc1
    s_cmp_lg_u32 s55, 5
    s_cbranch_scc1 L_noh
    v_bfe_u32 v124, v0, 4, 1
    v_mul_u32_u24 v124, 192, v124
    v_lshl_add_u32 v124, v1, 3, v124
    v_lshrrev_b32 v56, 5, v0
    v_lshl_add_u32 v124, v56, 2, v124
    v_add_u32 v124, 155904, v124
    s_mov_b32 s59, 0
    s_waitcnt vmcnt(2)
    s_branch Lpc26
Lp25:
    s_add_u32 s59, s59, 1
    buffer_load_dwordx4 v[96:99], v7, s[32:35], s99 offen offset:0 sc1
    buffer_load_dwordx4 v[100:103], v7, s[32:35], s99 offen offset:1024 sc1
    buffer_load_dwordx4 v[104:107], v7, s[32:35], s99 offen offset:2048 sc1
    buffer_load_dwordx4 v[108:111], v7, s[32:35], s99 offen offset:3072 sc1
    buffer_load_dwordx4 v[112:115], v7, s[32:35], s100 offen offset:0 sc1
    buffer_load_dwordx4 v[116:119], v7, s[32:35], s100 offen offset:1024 sc1
    buffer_load_dwordx4 v[48:51], v7, s[32:35], s100 offen offset:2048 sc1
    buffer_load_dwordx4 v[52:55], v7, s[32:35], s100 offen offset:3072 sc1
    s_waitcnt vmcnt(0)
Lpc26:
    v_xor_b32 v96, s45, v96
    v_xor_b32 v97, s46, v97
    v_xor_b32 v98, s47, v98
    v_xor_b32 v99, s96, v99
    v_or3_b32 v5, v96, v97, v98
    v_mov_b32 v127, v99
    v_xor_b32 v100, s45, v100
    v_xor_b32 v101, s46, v101
    v_xor_b32 v102, s47, v102
    v_xor_b32 v103, s96, v103
    v_or3_b32 v5, v5, v100, v101
    v_or_b32 v5, v5, v102
    v_or_b32 v127, v127, v103
    v_xor_b32 v104, s45, v104
    v_xor_b32 v105, s46, v105
    v_xor_b32 v106, s47, v106
    v_xor_b32 v107, s96, v107
    v_or3_b32 v5, v5, v104, v105
    v_or_b32 v5, v5, v106
    v_or_b32 v127, v127, v107
    v_xor_b32 v108, s45, v108
    v_xor_b32 v109, s46, v109
    v_xor_b32 v110, s47, v110
    v_xor_b32 v111, s96, v111
    v_or3_b32 v5, v5, v108, v109
    v_or_b32 v5, v5, v110
    v_or_b32 v127, v127, v111
    v_xor_b32 v112, s45, v112
    v_xor_b32 v113, s46, v113
    v_xor_b32 v114, s47, v114
    v_xor_b32 v115, s96, v115
    v_or3_b32 v5, v5, v112, v113
    v_or_b32 v5, v5, v114
    v_or_b32 v127, v127, v115
    v_xor_b32 v116, s45, v116
    v_xor_b32 v117, s46, v117
    v_xor_b32 v118, s47, v118
    v_xor_b32 v119, s96, v119
    v_or3_b32 v5, v5, v116, v117
    v_or_b32 v5, v5, v118
    v_or_b32 v127, v127, v119
    v_xor_b32 v48, s45, v48
    v_xor_b32 v49, s46, v49
    v_xor_b32 v50, s47, v50
    v_xor_b32 v51, s96, v51
    v_or3_b32 v5, v5, v48, v49
    v_or_b32 v5, v5, v50
    v_or_b32 v127, v127, v51
    v_xor_b32 v52, s45, v52
    v_xor_b32 v53, s46, v53
    v_xor_b32 v54, s47, v54
    v_xor_b32 v55, s96, v55
    v_or3_b32 v5, v5, v52, v53
    v_or_b32 v5, v5, v54
    v_or_b32 v127, v127, v55
    v_and_or_b32 v5, v127, s101, v5
    v_and_b32 v5, 0xff, v5
    v_cmp_ne_u32 vcc, 0, v5
    s_nop 0
    s_cbranch_vccz Lpd27
    s_cmp_lt_u32 s59, 400000
    s_cbranch_scc1 Lp25
Lpd27:
    v_and_b32 v99, v99, v3
    v_and_b32 v103, v103, v3
    v_and_b32 v107, v107, v3
    v_and_b32 v111, v111, v3
    v_and_b32 v115, v115, v3
    v_and_b32 v119, v119, v3
    v_and_b32 v51, v51, v3
    v_and_b32 v55, v55, v3
    v_pk_add_f32 v[96:97], v[96:97], v[100:101]
    v_pk_add_f32 v[98:99], v[98:99], v[102:103]
    v_pk_add_f32 v[104:105], v[104:105], v[108:109]
    v_pk_add_f32 v[106:107], v[106:107], v[110:111]
    v_pk_add_f32 v[112:113], v[112:113], v[116:117]
    v_pk_add_f32 v[114:115], v[114:115], v[118:119]
    v_pk_add_f32 v[48:49], v[48:49], v[52:53]
    v_pk_add_f32 v[50:51], v[50:51], v[54:55]
    v_pk_add_f32 v[96:97], v[96:97], v[104:105]
    v_pk_add_f32 v[98:99], v[98:99], v[106:107]
    v_pk_add_f32 v[112:113], v[112:113], v[48:49]
    v_pk_add_f32 v[114:115], v[114:115], v[50:51]
    v_pk_add_f32 v[96:97], v[96:97], v[112:113]
    v_pk_add_f32 v[98:99], v[98:99], v[114:115]
    s_nop 1
    v_permlane32_swap_b32 v96, v98
    v_permlane32_swap_b32 v97, v99
    v_cvt_pk_bf16_f32 v96, 0, v96
    v_cvt_pk_bf16_f32 v97, 0, v97
    v_cvt_pk_bf16_f32 v98, 0, v98
    v_cvt_pk_bf16_f32 v99, 0, v99
    v_mul_f32 v96, 0xbfb8aa3b, v96
    v_mul_f32 v97, 0xbfb8aa3b, v97
    v_exp_f32 v96, v96
    v_exp_f32 v97, v97
    v_add_f32 v96, 1.0, v96
    v_add_f32 v97, 1.0, v97
    v_rcp_f32 v96, v96
    v_rcp_f32 v97, v97
    v_cvt_pk_bf16_f32 v96, 0, v96
    v_cvt_pk_bf16_f32 v97, 0, v97
    v_mul_f32 v96, v96, v98
    v_mul_f32 v97, v97, v99
    v_cvt_pk_bf16_f32 v56, v96, v97
    ds_write_b32 v124, v56
    s_waitcnt lgkmcnt(0)
L_noh:
    s_barrier
    ds_read_b64_tr_b16 v[64:65], v9 offset:49152
    ds_read_b64_tr_b16 v[66:67], v9 offset:53248
    ds_read_b64_tr_b16 v[68:69], v9 offset:57344
    ds_read_b64_tr_b16 v[70:71], v9 offset:61440
    s_waitcnt lgkmcnt(2)
    v_mfma_f32_16x16x32_bf16 v[72:75], v[64:67], v[40:43], v[72:75]
    s_waitcnt lgkmcnt(0)
    v_mfma_f32_16x16x32_bf16 v[72:75], v[68:71], v[44:47], v[72:75]
    s_mov_b32 exec_lo, 0xf000f
    s_mov_b32 exec_hi, 0xf000f
    v_mov_b32 v5, 6
    s_cmp_lg_u32 s98, 0
    s_nop 3
    v_and_or_b32 v76, v72, v3, s45
    v_and_or_b32 v77, v73, v3, s46
    v_and_or_b32 v78, v74, v3, s47
    v_and_or_b32 v79, v75, v3, s97
    s_cbranch_scc1 L_ofar
    buffer_store_dwordx4 v[76:79], v12, s[32:35], s56 offen
L_ostored:
    s_barrier
    s_mov_b64 exec, -1
    s_mov_b32 s59, 0
    s_waitcnt vmcnt(1)
    s_branch Lpc29
Lp28:
    s_add_u32 s59, s59, 1
    buffer_load_dwordx4 v[80:83], v13, s[32:35], s57 offen offset:0 sc1
    buffer_load_dwordx4 v[84:87], v13, s[32:35], s57 offen offset:128 sc1
    s_waitcnt vmcnt(0)
Lpc29:
    v_xor_b32 v80, s45, v80
    v_xor_b32 v81, s46, v81
    v_xor_b32 v82, s47, v82
    v_xor_b32 v83, s97, v83
    v_or3_b32 v5, v80, v81, v82
    v_or_b32 v5, v5, v83
    v_xor_b32 v84, s45, v84
    v_xor_b32 v85, s46, v85
    v_xor_b32 v86, s47, v86
    v_xor_b32 v87, s97, v87
    v_or3_b32 v5, v5, v84, v85
    v_or3_b32 v5, v5, v86, v87
    v_and_b32 v5, 0xff, v5
    v_cmp_ne_u32 vcc, 0, v5
    s_nop 0
    s_cbranch_vccz Lpd30
    s_cmp_lt_u32 s59, 400000
    s_cbranch_scc1 Lp28
Lpd30:
    s_mov_b32 s59, 0x3fb8aa3b
    v_max_f32 v88, v80, v84
    s_nop 1
    v_max_f32_dpp v88, v88, v88 row_ror:8 row_mask:0xf bank_mask:0xf
    v_mov_b32 v89, v88
    s_nop 1
    v_permlane16_swap_b32 v88, v89
    v_max_f32 v88, v88, v89
    v_mov_b32 v89, v88
    s_nop 1
    v_permlane32_swap_b32 v88, v89
    v_max_f32 v88, v88, v89
    v_sub_f32 v80, v80, v88
    v_sub_f32 v84, v84, v88
    v_mul_f32 v80, s59, v80
    v_mul_f32 v84, s59, v84
    v_exp_f32 v80, v80
    v_exp_f32 v84, v84
    v_mul_f32 v88, v80, v81
    v_fmac_f32 v88, v84, v85
    s_nop 1
    v_add_f32_dpp v88, v88, v88 row_ror:8 row_mask:0xf bank_mask:0xf
    v_mov_b32 v89, v88
    s_nop 1
    v_permlane16_swap_b32 v88, v89
    v_add_f32 v88, v88, v89
    v_mov_b32 v89, v88
    s_nop 1
    v_permlane32_swap_b32 v88, v89
    v_add_f32 v88, v88, v89
    v_rcp_f32 v88, v88
    s_nop 0
    v_mul_f32 v80, v80, v88
    v_mul_f32 v84, v84, v88
    s_mov_b32 s59, 0
L_side:
    v_readfirstlane_b32 s29, v122
    s_add_u32 s59, s59, 1
    s_cmp_lg_u32 s29, 0
    s_cbranch_scc1 L_sideok
    s_cmp_ge_u32 s59, 400000
    s_cbranch_scc1 L_sideok
    buffer_load_dword v122, v123, s[24:27], 0 offen sc1
    s_waitcnt vmcnt(0)
    s_branch L_side
L_sideok:
    s_and_b32 s29, s29, 2
    s_lshl_b32 s29, s29, 12
    s_add_u32 s92, s92, s29
    s_add_u32 s28, s28, s29
    buffer_load_dwordx4 v[16:19], v10, s[32:35], s58 offen offset:0 sc1
    buffer_load_dwordx4 v[20:23], v10, s[32:35], s91 offen offset:0 sc1
    s_cmp_ge_u32 s55, 4
    s_cbranch_scc1 L_nopre
    v_mov_b32 v40, 0
    v_mov_b32 v41, 0
    v_mov_b32 v42, 0
    v_mov_b32 v43, 0
    v_mov_b32 v44, 0
    v_mov_b32 v45, 0
    v_mov_b32 v46, 0
    v_mov_b32 v47, 0
    v_mov_b32 v48, 0
    v_mov_b32 v49, 0
    v_mov_b32 v50, 0
    v_mov_b32 v51, 0
    v_mov_b32 v52, 0
    v_mov_b32 v53, 0
    v_mov_b32 v54, 0
    v_mov_b32 v55, 0
    v_mov_b32 v56, 0
    v_mov_b32 v57, 0
    v_mov_b32 v58, 0
    v_mov_b32 v59, 0
    v_mov_b32 v60, 0
    v_mov_b32 v61, 0
    v_mov_b32 v62, 0
    v_mov_b32 v63, 0
Lw31:
    ds_read_b32 v5, v4
    s_waitcnt lgkmcnt(0)
    v_cmp_gt_u32 vcc, v94, v5
    s_nop 0
    s_cbranch_vccnz Lw31
    s_mov_b32 exec_lo, 0xc000c
    s_mov_b32 exec_hi, 0xc000c
    ds_read2_b64 v[56:59], v91 offset0:0 offset1:4
    ds_read2_b64 v[60:63], v91 offset0:8 offset1:12
    s_mov_b64 exec, -1
    ds_read_b64_tr_b16 v[32:33], v15 offset:16384
    ds_read_b64_tr_b16 v[34:35], v15 offset:18432
    ds_read_b64_tr_b16 v[36:37], v15 offset:20480
    ds_read_b64_tr_b16 v[38:39], v15 offset:22528
Lw32:
    ds_read_b32 v5, v4
    s_waitcnt lgkmcnt(0)
    v_cmp_gt_u32 vcc, 12, v5
    s_nop 0
    s_and_b64 vcc, vcc, 0xf
    s_cbranch_vccnz Lw32
    ds_read_b64_tr_b16 v[96:97], v15 offset:0
    ds_read_b64_tr_b16 v[98:99], v15 offset:2048
    ds_read_b64_tr_b16 v[100:101], v15 offset:4096
    ds_read_b64_tr_b16 v[102:103], v15 offset:6144
    ds_read_b64_tr_b16 v[104:105], v15 offset:8192
    ds_read_b64_tr_b16 v[106:107], v15 offset:10240
    ds_read_b64_tr_b16 v[108:109], v15 offset:12288
    ds_read_b64_tr_b16 v[110:111], v15 offset:14336
    v_mfma_f32_16x16x32_bf16 v[64:67], v[56:59], v[32:35], 0
    v_mfma_f32_16x16x32_bf16 v[64:67], v[60:63], v[36:39], v[64:67]
L_nopre:
    s_mov_b32 s59, 0
    s_waitcnt vmcnt(0)
L_ochk:
    v_xor_b32 v16, s45, v16
    v_xor_b32 v17, s46, v17
    v_xor_b32 v18, s47, v18
    v_xor_b32 v19, s97, v19
    v_xor_b32 v20, s45, v20
    v_xor_b32 v21, s46, v21
    v_xor_b32 v22, s47, v22
    v_xor_b32 v23, s97, v23
L_ocomb:
    v_pk_mul_f32 v[24:25], v[16:17], v[80:81] op_sel_hi:[1,0]
    v_pk_mul_f32 v[26:27], v[18:19], v[80:81] op_sel_hi:[1,0]
    v_pk_fma_f32 v[24:25], v[20:21], v[84:85], v[24:25] op_sel_hi:[1,0,1]
    v_pk_fma_f32 v[26:27], v[22:23], v[84:85], v[26:27] op_sel_hi:[1,0,1]
    v_or3_b32 v5, v16, v17, v18
    v_or3_b32 v5, v5, v19, v20
    v_permlane32_swap_b32 v24, v26
    v_permlane32_swap_b32 v25, v27
    v_add_f32 v24, v24, v26
    v_add_f32 v25, v25, v27
    v_or3_b32 v5, v5, v21, v22
    v_or_b32 v5, v5, v23
    v_permlane16_swap_b32 v24, v25
    v_add_f32 v24, v24, v25
    v_and_b32 v5, 0xff, v5
    v_cmp_ne_u32 vcc, 0, v5
    v_add_f32_dpp v24, v24, v24 row_ror:8 row_mask:0xf bank_mask:0xf
    v_cvt_pk_bf16_f32 v24, v24, v24
    s_cbranch_vccnz L_oretry
L_ogood:
    ds_write_b16 v14, v24
    s_cmp_ge_u32 s55, 4
    s_cbranch_scc1 L_final
    s_mov_b32 exec_lo, 0x30003
    s_mov_b32 exec_hi, 0x30003
    s_waitcnt lgkmcnt(0)
    s_barrier
    ds_read_b128 v[40:43], v90 offset:0
    ds_read_b128 v[44:47], v90 offset:64
    ds_read_b128 v[48:51], v90 offset:128
    ds_read_b128 v[52:55], v90 offset:192
    s_mov_b64 exec, -1
    s_waitcnt lgkmcnt(3)
    v_mfma_f32_16x16x32_bf16 v[64:67], v[40:43], v[96:99], v[64:67]
    s_waitcnt lgkmcnt(2)
    v_mfma_f32_16x16x32_bf16 v[64:67], v[44:47], v[100:103], v[64:67]
    s_waitcnt lgkmcnt(1)
    v_mfma_f32_16x16x32_bf16 v[64:67], v[48:51], v[104:107], v[64:67]
    s_waitcnt lgkmcnt(0)
    v_mfma_f32_16x16x32_bf16 v[64:67], v[52:55], v[108:111], v[64:67]
    s_mov_b64 exec, 0xffff
    s_nop 6
    v_and_or_b32 v68, v64, v3, s45
    v_and_or_b32 v69, v65, v3, s46
    v_and_or_b32 v70, v66, v3, s47
    v_and_or_b32 v71, v67, v3, s48
    buffer_store_dwordx4 v[68:71], v92, s[32:35], s92 offen sc1
    s_endpgm
L_ofar:
    buffer_store_dwordx4 v[76:79], v12, s[32:35], s56 offen sc1
    s_branch L_ostored
L_oretry:
    s_add_u32 s59, s59, 1
    s_cmp_ge_u32 s59, 400000
    s_cbranch_scc1 L_ogood
    buffer_load_dwordx4 v[16:19], v10, s[32:35], s58 offen offset:0 sc1
    buffer_load_dwordx4 v[20:23], v10, s[32:35], s91 offen offset:0 sc1
    s_waitcnt vmcnt(0)
    s_branch L_ochk
L_final:
    s_waitcnt lgkmcnt(0)
    s_barrier
    s_cmp_lg_u32 s55, 4
    s_cbranch_scc1 L_fin_exit
    s_cmp_lg_u32 s22, 0
    s_cbranch_scc1 L_fin_exit
    s_mov_b32 s57, s28
    s_mov_b32 s59, 0
    v_lshlrev_b32 v121, 16, v121
    buffer_load_dwordx4 v[16:19], v7, s[32:35], s57 offen offset:0 sc1
    buffer_load_dwordx4 v[20:23], v7, s[32:35], s57 offen offset:1024 sc1
    buffer_load_dwordx4 v[24:27], v7, s[32:35], s57 offen offset:2048 sc1
    buffer_load_dwordx4 v[28:31], v7, s[32:35], s57 offen offset:3072 sc1
L_fp:
    buffer_load_dwordx4 v[32:35], v7, s[32:35], s57 offen offset:0 sc1
    buffer_load_dwordx4 v[36:39], v7, s[32:35], s57 offen offset:1024 sc1
    buffer_load_dwordx4 v[40:43], v7, s[32:35], s57 offen offset:2048 sc1
    buffer_load_dwordx4 v[44:47], v7, s[32:35], s57 offen offset:3072 sc1
    s_add_u32 s59, s59, 1
    s_waitcnt vmcnt(4)
    v_xor_b32 v16, s45, v16
    v_xor_b32 v17, s46, v17
    v_xor_b32 v18, s47, v18
    v_xor_b32 v19, s48, v19
    v_xor_b32 v20, s45, v20
    v_xor_b32 v21, s46, v21
    v_xor_b32 v22, s47, v22
    v_xor_b32 v23, s48, v23
    v_xor_b32 v24, s45, v24
    v_xor_b32 v25, s46, v25
    v_xor_b32 v26, s47, v26
    v_xor_b32 v27, s48, v27
    v_xor_b32 v28, s45, v28
    v_xor_b32 v29, s46, v29
    v_xor_b32 v30, s47, v30
    v_xor_b32 v31, s48, v31
    v_pk_add_f32 v[52:53], v[16:17], v[20:21]
    v_pk_add_f32 v[56:57], v[24:25], v[28:29]
    v_pk_add_f32 v[54:55], v[18:19], v[22:23]
    v_pk_add_f32 v[58:59], v[26:27], v[30:31]
    v_or3_b32 v5, v16, v17, v18
    v_pk_add_f32 v[48:49], v[52:53], v[56:57]
    v_pk_add_f32 v[50:51], v[54:55], v[58:59]
    v_or3_b32 v5, v5, v19, v20
    v_or3_b32 v5, v5, v21, v22
    v_permlane32_swap_b32 v48, v49
    v_permlane32_swap_b32 v50, v51
    v_add_f32 v48, v48, v49
    v_add_f32 v49, v50, v51
    v_or3_b32 v5, v5, v23, v24
    v_or3_b32 v5, v5, v25, v26
    v_permlane16_swap_b32 v48, v49
    v_add_f32 v48, v48, v49
    v_or3_b32 v5, v5, v27, v28
    v_or3_b32 v5, v5, v29, v30
    v_add_f32_dpp v48, v48, v48 row_ror:8 row_mask:0xf bank_mask:0xf
    v_or_b32 v5, v5, v31
    v_and_b32 v5, 0xff, v5
    v_cmp_ne_u32 vcc, 0, v5
    v_mov_b32 v49, v48
    s_cbranch_vccz L_fok
    buffer_load_dwordx4 v[16:19], v7, s[32:35], s57 offen offset:0 sc1
    buffer_load_dwordx4 v[20:23], v7, s[32:35], s57 offen offset:1024 sc1
    buffer_load_dwordx4 v[24:27], v7, s[32:35], s57 offen offset:2048 sc1
    buffer_load_dwordx4 v[28:31], v7, s[32:35], s57 offen offset:3072 sc1
    s_waitcnt vmcnt(4)
    v_xor_b32 v32, s45, v32
    v_xor_b32 v33, s46, v33
    v_xor_b32 v34, s47, v34
    v_xor_b32 v35, s48, v35
    v_xor_b32 v36, s45, v36
    v_xor_b32 v37, s46, v37
    v_xor_b32 v38, s47, v38
    v_xor_b32 v39, s48, v39
    v_xor_b32 v40, s45, v40
    v_xor_b32 v41, s46, v41
    v_xor_b32 v42, s47, v42
    v_xor_b32 v43, s48, v43
    v_xor_b32 v44, s45, v44
    v_xor_b32 v45, s46, v45
    v_xor_b32 v46, s47, v46
    v_xor_b32 v47, s48, v47
    v_pk_add_f32 v[52:53], v[32:33], v[36:37]
    v_pk_add_f32 v[56:57], v[40:41], v[44:45]
    v_pk_add_f32 v[54:55], v[34:35], v[38:39]
    v_pk_add_f32 v[58:59], v[42:43], v[46:47]
    v_or3_b32 v5, v32, v33, v34
    v_pk_add_f32 v[48:49], v[52:53], v[56:57]
    v_pk_add_f32 v[50:51], v[54:55], v[58:59]
    v_or3_b32 v5, v5, v35, v36
    v_or3_b32 v5, v5, v37, v38
    v_permlane32_swap_b32 v48, v49
    v_permlane32_swap_b32 v50, v51
    v_add_f32 v48, v48, v49
    v_add_f32 v49, v50, v51
    v_or3_b32 v5, v5, v39, v40
    v_or3_b32 v5, v5, v41, v42
    v_permlane16_swap_b32 v48, v49
    v_add_f32 v48, v48, v49
    v_or3_b32 v5, v5, v43, v44
    v_or3_b32 v5, v5, v45, v46
    v_add_f32_dpp v48, v48, v48 row_ror:8 row_mask:0xf bank_mask:0xf
    v_or_b32 v5, v5, v47
    v_and_b32 v5, 0xff, v5
    v_cmp_ne_u32 vcc, 0, v5
    v_mov_b32 v49, v48
    s_cbranch_vccz L_fok
    s_cmp_lt_u32 s59, 400000
    s_cbranch_scc1 L_fp
L_fok:
    s_nop 0
    v_permlane16_swap_b32 v48, v49
    v_cvt_pk_bf16_f32 v49, 0, v49
    v_cvt_pk_bf16_f32 v48, 0, v48
    s_mov_b32 exec_lo, 0xff
    s_mov_b32 exec_hi, 0xff
    v_mul_f32 v50, 0xbfb8aa3b, v49
    v_exp_f32 v50, v50
    s_nop 0
    v_add_f32 v50, 1.0, v50
    v_rcp_f32 v50, v50
    s_nop 0
    v_mul_f32 v49, v49, v50
    v_cvt_pk_bf16_f32 v49, 0, v49
    v_mul_f32 v48, v48, v49
    v_cvt_pk_bf16_f32 v48, 0, v48
    v_add_f32 v48, v121, v48
    v_cvt_pk_bf16_f32 v48, v48, v48
    buffer_store_short v48, v120, s[40:43], s31 offen
    s_cmp_lg_u32 s30, 0
    s_cbranch_scc1 L_fin_exit
    v_mov_b32 v52, s44
    v_mov_b32 v53, 0
    s_mov_b64 exec, 1
    buffer_store_dword v52, v53, s[32:35], 0 offen sc1
L_fin_exit:
L_exit:
    s_endpgm
L_codeend:

.section .rodata,"a"
.p2align 6
.amdhsa_kernel recurrent_scan__sliding_block_cached__glu_gated_glu__decode_kernel
  .amdhsa_next_free_vgpr 128
  .amdhsa_next_free_sgpr 102
  .amdhsa_accum_offset 128
  .amdhsa_group_segment_fixed_size 0
  .amdhsa_kernarg_size 96
  .amdhsa_user_sgpr_count 2
  .amdhsa_user_sgpr_kernarg_segment_ptr 1
  .amdhsa_system_sgpr_workgroup_id_x 1
  .amdhsa_float_denorm_mode_32 3
.end_amdhsa_kernel
```
